```python
import torch

def _softmax(x, axis=-1):
    return torch.softmax(x, dim=axis)
def _gelu(x):
    return torch.nn.functional.gelu(x, approximate="tanh")
def _silu(x):
    return torch.nn.functional.silu(x)
def _sigmoid(x):
    return torch.sigmoid(x)
def _layernorm(x, axis=-1, eps=1e-5):
    m = x.mean(dim=axis, keepdim=True)
    v = x.var(dim=axis, keepdim=True, unbiased=False)
    return (x - m) / torch.sqrt(v + eps)
def _scatter_add(tgt, idx, src, axis=0):
    return tgt.clone().index_add_(axis, idx, src)
def _segment_sum(src, seg, n):
    out = torch.zeros((n,) + src.shape[1:], dtype=src.dtype)
    return out.index_add_(0, seg, src)
def _pad(x, pw):
    flat = tuple(v for pair in reversed(pw) for v in pair)
    return torch.nn.functional.pad(x, flat)

kernel_name = 'gather_scatter__molecular_angular_gemnet__graph'

def setup_inputs():

    _w = (lambda a: (lambda t: t.to(torch.bfloat16) if t.is_floating_point() else t)(torch.as_tensor(a)))
    N, deg, De, L = 10000, 16, 16, 2
    E = N * deg
    T = E * deg
    NR = 8
    dist = torch.rand(E).to(float)
    angle = (torch.rand(T) * torch.pi).to(float)
    centers = torch.linspace(0.0, 1.0, NR).to(float)
    ang_freq = torch.arange(1, L + 1).to(float)
    return {
        "m": _w((lambda *s: torch.randn(*s, dtype=torch.bfloat16) * 0.05)(E, De)),
        "idx_in": _w((lambda lo, hi, *s: torch.randint(lo, hi, s))(0, E, T).to(torch.int64)),
        "idx_out": _w((lambda lo, hi, *s: torch.randint(lo, hi, s))(0, E, T).to(torch.int64)),
        "dist": _w(dist),
        "angle": _w(angle),
        "centers": _w(centers),
        "ang_freq": _w(ang_freq),
        "w_rbf": _w((lambda *s: torch.randn(*s, dtype=torch.bfloat16) * 0.2)(NR, De)),
        "w_sbf": _w((lambda *s: torch.randn(*s, dtype=torch.bfloat16) * 0.2)(NR * L, De)),
        "w_down": _w((lambda *s: torch.randn(*s, dtype=torch.bfloat16) * 0.2)(De, De)),
        "w_up": _w((lambda *s: torch.randn(*s, dtype=torch.bfloat16) * 0.2)(De, De)),
    }

def reference(m, idx_in, idx_out, dist, angle, centers, ang_freq, w_rbf, w_sbf, w_down, w_up):
    E, De = m.shape[0], m.shape[1]
    NR = centers.shape[0]
    L = ang_freq.shape[0]
    rbf = torch.exp(-10.0 * (dist[:, None] - centers[None, :]) ** 2)
    cbf = torch.cos(ang_freq[None, :] * angle[:, None])
    rbf_t = rbf[idx_out]
    sbf = torch.reshape(rbf_t[:, :, None] * cbf[:, None, :], (-1, NR * L))
    x = (m[idx_in] @ w_down) * (sbf @ w_sbf)
    agg = _segment_sum(x, idx_out, E)
    return m + (agg @ w_up) * (rbf @ w_rbf)
```

```asm
; @launch kernel=part_kernel grid=(251,1,1) block=(1024,1,1) lds=63488
; @launch kernel=acc_kernel grid=(256,1,1) block=(640,1,1) lds=145152
.amdgcn_target "amdgcn-amd-amdhsa--gfx950"
.text
.globl part_kernel
.p2align 8
.type part_kernel,@function
part_kernel:
s_cmp_ge_u32 s2, 250
s_cbranch_scc1 K1_BLOB
v_mov_b32 v96, 0
s_load_dwordx4 s[24:27], s[0:1], 8
s_load_dwordx2 s[28:29], s[0:1], 32
s_load_dwordx2 s[32:33], s[0:1], 104
s_load_dwordx2 s[8:9], s[0:1], 0
v_lshlrev_b32 v1, 4, v0
v_lshlrev_b32 v2, 3, v0
v_lshlrev_b32 v3, 2, v0
s_mul_i32 s34, s2, 40960
s_add_u32 s35, s34, 16384
s_add_u32 s36, s34, 32768
s_mul_i32 s37, s2, 20480
s_add_u32 s38, s37, 8192
s_add_u32 s39, s37, 16384
v_and_b32 v74, 0x3fc, v3
v_mov_b32 v75, 0
v_mov_b32 v78, 4
ds_write_b32 v74, v75 offset:0
s_mov_b32 s6, 10240000
s_mov_b32 s7, 0x00020000
s_mov_b32 s30, 5120000
s_mov_b32 s31, 0x00020000
s_waitcnt lgkmcnt(0)
s_setprio 3
s_mov_b32 s4, s26
s_mov_b32 s5, s27
buffer_load_dwordx4 v[4:7], v1, s[4:7], s34 offen nt
buffer_load_dwordx4 v[8:11], v1, s[4:7], s35 offen nt
buffer_load_dwordx2 v[12:13], v2, s[4:7], s36 offen nt
s_setprio 0
s_barrier
buffer_load_dwordx2 v[28:29], v2, s[28:31], s37 offen nt
buffer_load_dwordx2 v[30:31], v2, s[28:31], s38 offen nt
buffer_load_dword v32, v3, s[28:31], s39 offen nt
s_mov_b32 s26, 10240000
s_mov_b32 s27, 0x00020000
buffer_load_dwordx4 v[16:19], v1, s[24:27], s34 offen nt
buffer_load_dwordx4 v[20:23], v1, s[24:27], s35 offen nt
buffer_load_dwordx2 v[24:25], v2, s[24:27], s36 offen nt
s_mov_b32 s16, s32
s_mov_b32 s17, s33
s_mov_b32 s18, 15360000
s_mov_b32 s19, 0x00020000
s_add_u32 s20, s32, 20480000
s_addc_u32 s21, s33, 0
s_mov_b32 s22, 655360
s_mov_b32 s23, 0x00020000
s_mov_b32 s41, 6871948
s_mov_b32 s42, -625
s_mov_b32 s43, 0xfc000000
s_mov_b32 s47, 13074432
s_mov_b32 s48, 33554432
v_and_b32 v79, 63, v0
v_lshlrev_b32 v88, 4, v79
s_waitcnt vmcnt(8)
v_mul_hi_u32_u24 v74, s41, v4
v_lshlrev_b32 v34, 2, v74
ds_add_rtn_u32 v44, v34, v78 offset:0
v_mad_i32_i24 v74, v74, s42, v4
v_and_or_b32 v75, v74, 15, 16
v_lshlrev_b32 v74, 22, v74
v_and_or_b32 v54, v74, s43, v75
v_mul_hi_u32_u24 v74, s41, v5
v_lshlrev_b32 v35, 2, v74
ds_add_rtn_u32 v45, v35, v78 offset:0
v_mad_i32_i24 v74, v74, s42, v5
v_and_or_b32 v75, v74, 15, 16
v_lshlrev_b32 v74, 22, v74
v_and_or_b32 v55, v74, s43, v75
v_mul_hi_u32_u24 v74, s41, v6
v_lshlrev_b32 v36, 2, v74
ds_add_rtn_u32 v46, v36, v78 offset:0
v_mad_i32_i24 v74, v74, s42, v6
v_and_or_b32 v75, v74, 15, 16
v_lshlrev_b32 v74, 22, v74
v_and_or_b32 v56, v74, s43, v75
v_mul_hi_u32_u24 v74, s41, v7
v_lshlrev_b32 v37, 2, v74
ds_add_rtn_u32 v47, v37, v78 offset:0
v_mad_i32_i24 v74, v74, s42, v7
v_and_or_b32 v75, v74, 15, 16
v_lshlrev_b32 v74, 22, v74
v_and_or_b32 v57, v74, s43, v75
s_waitcnt vmcnt(7)
v_mul_hi_u32_u24 v74, s41, v8
v_lshlrev_b32 v38, 2, v74
ds_add_rtn_u32 v48, v38, v78 offset:0
v_mad_i32_i24 v74, v74, s42, v8
v_and_or_b32 v75, v74, 15, 16
v_lshlrev_b32 v74, 22, v74
v_and_or_b32 v58, v74, s43, v75
v_mul_hi_u32_u24 v74, s41, v9
v_lshlrev_b32 v39, 2, v74
ds_add_rtn_u32 v49, v39, v78 offset:0
v_mad_i32_i24 v74, v74, s42, v9
v_and_or_b32 v75, v74, 15, 16
v_lshlrev_b32 v74, 22, v74
v_and_or_b32 v59, v74, s43, v75
v_mul_hi_u32_u24 v74, s41, v10
v_lshlrev_b32 v40, 2, v74
ds_add_rtn_u32 v50, v40, v78 offset:0
v_mad_i32_i24 v74, v74, s42, v10
v_and_or_b32 v75, v74, 15, 16
v_lshlrev_b32 v74, 22, v74
v_and_or_b32 v60, v74, s43, v75
v_mul_hi_u32_u24 v74, s41, v11
v_lshlrev_b32 v41, 2, v74
ds_add_rtn_u32 v51, v41, v78 offset:0
v_mad_i32_i24 v74, v74, s42, v11
v_and_or_b32 v75, v74, 15, 16
v_lshlrev_b32 v74, 22, v74
v_and_or_b32 v61, v74, s43, v75
s_waitcnt vmcnt(6)
v_mul_hi_u32_u24 v74, s41, v12
v_lshlrev_b32 v42, 2, v74
ds_add_rtn_u32 v52, v42, v78 offset:0
v_mad_i32_i24 v74, v74, s42, v12
v_and_or_b32 v75, v74, 15, 16
v_lshlrev_b32 v74, 22, v74
v_and_or_b32 v62, v74, s43, v75
v_mul_hi_u32_u24 v74, s41, v13
v_lshlrev_b32 v43, 2, v74
ds_add_rtn_u32 v53, v43, v78 offset:0
v_mad_i32_i24 v74, v74, s42, v13
v_and_or_b32 v75, v74, 15, 16
v_lshlrev_b32 v74, 22, v74
v_and_or_b32 v63, v74, s43, v75
v_readfirstlane_b32 s46, v0
s_waitcnt lgkmcnt(0)
s_barrier
ds_read_b128 v[80:83], v88 offset:0
s_waitcnt lgkmcnt(0)
v_add_u32 v85, v80, v81
v_add3_u32 v84, v85, v82, v83
v_mov_b32 v89, v84
s_nop 1
v_add_u32_dpp v89, v89, v89 row_shr:1 row_mask:0xf bank_mask:0xf bound_ctrl:0
s_nop 1
v_add_u32_dpp v89, v89, v89 row_shr:2 row_mask:0xf bank_mask:0xf bound_ctrl:0
s_nop 1
v_add_u32_dpp v89, v89, v89 row_shr:4 row_mask:0xf bank_mask:0xf bound_ctrl:0
s_nop 1
v_add_u32_dpp v89, v89, v89 row_shr:8 row_mask:0xf bank_mask:0xf bound_ctrl:0
s_nop 1
v_add_u32_dpp v89, v89, v89 row_bcast:15 row_mask:0xa bank_mask:0xf
s_nop 1
v_add_u32_dpp v89, v89, v89 row_bcast:31 row_mask:0xc bank_mask:0xf
v_sub_u32 v92, v89, v84
v_add_u32 v93, v92, v80
v_add_u32 v94, v92, v85
v_add_u32 v95, v94, v82
ds_write_b128 v88, v[92:95] offset:1024
s_lshr_b32 s50, s46, 2
v_and_b32 v6, 15, v0
v_add_u32 v6, s50, v6
s_movk_i32 s51, 1024
v_lshl_add_u32 v7, v6, 2, s51
ds_read2_b32 v[4:5], v7 offset0:0 offset1:1
ds_read_b32 v34, v34 offset:1024
ds_read_b32 v35, v35 offset:1024
ds_read_b32 v36, v36 offset:1024
ds_read_b32 v37, v37 offset:1024
ds_read_b32 v38, v38 offset:1024
ds_read_b32 v39, v39 offset:1024
ds_read_b32 v40, v40 offset:1024
ds_read_b32 v41, v41 offset:1024
ds_read_b32 v42, v42 offset:1024
ds_read_b32 v43, v43 offset:1024
s_mul_i32 s50, s2, 2622
s_lshr_b32 s50, s50, 16
s_mul_i32 s51, s50, 56
s_lshl_b32 s50, s2, 3
s_add_u32 s50, s50, s51
v_readlane_b32 s52, v89, 63
v_cmp_eq_u32 vcc, 0xff, v6
s_movk_i32 s51, 2560
v_mul_u32_u24 v7, s51, v6
v_mov_b32 v8, s52
s_waitcnt lgkmcnt(10)
v_cndmask_b32 v5, v5, v8, vcc
v_add_u32 v4, s34, v4
v_add_u32 v5, s34, v5
s_mov_b64 exec, 0xffff
buffer_store_dwordx2 v[4:5], v7, s[20:23], s50 offen sc0 sc1
s_mov_b64 exec, -1
s_waitcnt vmcnt(6) lgkmcnt(9)
v_add_u32 v34, v34, v44
v_lshrrev_b32 v44, 1, v34
ds_write_b16 v44, v28 offset:43008
s_waitcnt lgkmcnt(9)
v_add_u32 v35, v35, v45
v_lshrrev_b32 v45, 1, v35
ds_write_b16_d16_hi v45, v28 offset:43008
s_waitcnt lgkmcnt(9)
v_add_u32 v36, v36, v46
v_lshrrev_b32 v46, 1, v36
ds_write_b16 v46, v29 offset:43008
s_waitcnt lgkmcnt(9)
v_add_u32 v37, v37, v47
v_lshrrev_b32 v47, 1, v37
ds_write_b16_d16_hi v47, v29 offset:43008
s_waitcnt vmcnt(5) lgkmcnt(9)
v_add_u32 v38, v38, v48
v_lshrrev_b32 v48, 1, v38
ds_write_b16 v48, v30 offset:43008
s_waitcnt lgkmcnt(9)
v_add_u32 v39, v39, v49
v_lshrrev_b32 v49, 1, v39
ds_write_b16_d16_hi v49, v30 offset:43008
s_waitcnt lgkmcnt(9)
v_add_u32 v40, v40, v50
v_lshrrev_b32 v50, 1, v40
ds_write_b16 v50, v31 offset:43008
s_waitcnt lgkmcnt(9)
v_add_u32 v41, v41, v51
v_lshrrev_b32 v51, 1, v41
ds_write_b16_d16_hi v51, v31 offset:43008
s_waitcnt vmcnt(4) lgkmcnt(9)
v_add_u32 v42, v42, v52
v_lshrrev_b32 v52, 1, v42
ds_write_b16 v52, v32 offset:43008
s_waitcnt lgkmcnt(9)
v_add_u32 v43, v43, v53
v_lshrrev_b32 v53, 1, v43
ds_write_b16_d16_hi v53, v32 offset:43008
s_add_u32 s37, s37, 10240000
s_add_u32 s38, s37, 16384
s_waitcnt lgkmcnt(0)
s_barrier
ds_read_b128 v[8:11], v1 offset:43008
ds_read_b32 v12, v3 offset:59392
s_waitcnt lgkmcnt(1)
buffer_store_dwordx4 v[8:11], v1, s[16:19], s37 offen sc0 sc1
s_waitcnt lgkmcnt(0)
buffer_store_dword v12, v3, s[16:19], s38 offen sc0 sc1
s_waitcnt vmcnt(5)
v_lshl_add_u32 v74, v16, 8, s47
v_lshl_or_b32 v54, v16, 5, v54
v_and_or_b32 v54, v74, s48, v54
ds_write_b32 v34, v54 offset:2048
v_lshl_add_u32 v74, v17, 8, s47
v_lshl_or_b32 v55, v17, 5, v55
v_and_or_b32 v55, v74, s48, v55
ds_write_b32 v35, v55 offset:2048
v_lshl_add_u32 v74, v18, 8, s47
v_lshl_or_b32 v56, v18, 5, v56
v_and_or_b32 v56, v74, s48, v56
ds_write_b32 v36, v56 offset:2048
v_lshl_add_u32 v74, v19, 8, s47
v_lshl_or_b32 v57, v19, 5, v57
v_and_or_b32 v57, v74, s48, v57
ds_write_b32 v37, v57 offset:2048
s_waitcnt vmcnt(4)
v_lshl_add_u32 v74, v20, 8, s47
v_lshl_or_b32 v58, v20, 5, v58
v_and_or_b32 v58, v74, s48, v58
ds_write_b32 v38, v58 offset:2048
v_lshl_add_u32 v74, v21, 8, s47
v_lshl_or_b32 v59, v21, 5, v59
v_and_or_b32 v59, v74, s48, v59
ds_write_b32 v39, v59 offset:2048
v_lshl_add_u32 v74, v22, 8, s47
v_lshl_or_b32 v60, v22, 5, v60
v_and_or_b32 v60, v74, s48, v60
ds_write_b32 v40, v60 offset:2048
v_lshl_add_u32 v74, v23, 8, s47
v_lshl_or_b32 v61, v23, 5, v61
v_and_or_b32 v61, v74, s48, v61
ds_write_b32 v41, v61 offset:2048
s_waitcnt vmcnt(3)
v_lshl_add_u32 v74, v24, 8, s47
v_lshl_or_b32 v62, v24, 5, v62
v_and_or_b32 v62, v74, s48, v62
ds_write_b32 v42, v62 offset:2048
v_lshl_add_u32 v74, v25, 8, s47
v_lshl_or_b32 v63, v25, 5, v63
v_and_or_b32 v63, v74, s48, v63
ds_write_b32 v43, v63 offset:2048
s_waitcnt lgkmcnt(0)
s_barrier
ds_read_b128 v[28:31], v1 offset:2048
ds_read_b128 v[16:19], v1 offset:18432
ds_read_b64 v[20:21], v2 offset:34816
s_waitcnt lgkmcnt(2)
buffer_store_dwordx4 v[28:31], v1, s[16:19], s34 offen sc0 sc1
s_waitcnt lgkmcnt(1)
buffer_store_dwordx4 v[16:19], v1, s[16:19], s35 offen sc0 sc1
s_waitcnt lgkmcnt(0)
buffer_store_dwordx2 v[20:21], v2, s[16:19], s36 offen sc0 sc1
K1_END:
s_endpgm
K1_BLOB:
s_cmp_gt_u32 s2, 250
s_cbranch_scc1 K1_END
v_readfirstlane_b32 s3, v0
s_cmp_ge_u32 s3, 64
s_cbranch_scc1 K1_END
s_load_dwordx2 s[8:9], s[0:1], 40
s_load_dwordx8 s[24:31], s[0:1], 56
s_load_dwordx2 s[32:33], s[0:1], 104
v_and_b32 v2, 15, v0
v_bfe_u32 v12, v0, 4, 2
v_lshlrev_b32 v11, 1, v2
v_lshl_or_b32 v13, v12, 7, v11
v_lshl_or_b32 v14, v12, 8, v11
v_lshlrev_b32 v15, 3, v12
v_and_b32 v15, 8, v15
s_mov_b32 s10, 16
s_mov_b32 s11, 0x00020000
s_waitcnt lgkmcnt(0)
buffer_load_dwordx2 v[70:71], v15, s[8:11], 0 offen
v_lshl_or_b32 v3, v15, 5, v11
s_mov_b32 s20, s24
s_mov_b32 s21, s25
s_mov_b32 s22, 256
s_mov_b32 s23, 0x00020000
buffer_load_ushort v60, v13, s[20:23], 0 offen offset:0
buffer_load_ushort v61, v13, s[20:23], 0 offen offset:32
buffer_load_ushort v62, v13, s[20:23], 0 offen offset:64
buffer_load_ushort v63, v13, s[20:23], 0 offen offset:96
s_mov_b32 s20, s26
s_mov_b32 s21, s27
s_mov_b32 s22, 512
s_mov_b32 s23, 0x00020000
buffer_load_ushort v52, v14, s[20:23], 0 offen offset:0
buffer_load_ushort v53, v14, s[20:23], 0 offen offset:64
buffer_load_ushort v54, v14, s[20:23], 0 offen offset:128
buffer_load_ushort v55, v14, s[20:23], 0 offen offset:192
s_mov_b32 s20, s26
s_mov_b32 s21, s27
s_mov_b32 s22, 512
s_mov_b32 s23, 0x00020000
buffer_load_ushort v56, v14, s[20:23], 0 offen offset:32
buffer_load_ushort v57, v14, s[20:23], 0 offen offset:96
buffer_load_ushort v58, v14, s[20:23], 0 offen offset:160
buffer_load_ushort v59, v14, s[20:23], 0 offen offset:224
s_mov_b32 s20, s28
s_mov_b32 s21, s29
s_mov_b32 s22, 512
s_mov_b32 s23, 0x00020000
buffer_load_ushort v40, v3, s[20:23], 0 offen offset:0
buffer_load_ushort v41, v3, s[20:23], 0 offen offset:32
buffer_load_ushort v42, v3, s[20:23], 0 offen offset:64
buffer_load_ushort v43, v3, s[20:23], 0 offen offset:96
buffer_load_ushort v44, v3, s[20:23], 0 offen offset:128
buffer_load_ushort v45, v3, s[20:23], 0 offen offset:160
buffer_load_ushort v46, v3, s[20:23], 0 offen offset:192
buffer_load_ushort v47, v3, s[20:23], 0 offen offset:224
s_mov_b32 s20, s30
s_mov_b32 s21, s31
s_mov_b32 s22, 512
s_mov_b32 s23, 0x00020000
buffer_load_ushort v48, v13, s[20:23], 0 offen offset:0
buffer_load_ushort v49, v13, s[20:23], 0 offen offset:32
buffer_load_ushort v50, v13, s[20:23], 0 offen offset:64
buffer_load_ushort v51, v13, s[20:23], 0 offen offset:96
s_add_u32 s20, s32, 21135360
s_addc_u32 s21, s33, 0
s_mov_b32 s22, 5120
s_mov_b32 s23, 0x00020000
v_lshlrev_b32 v1, 4, v0
v_cmp_gt_u32 vcc, 32, v0
s_waitcnt vmcnt(0)
v_lshl_or_b32 v20, v41, 16, v40
v_lshl_or_b32 v21, v43, 16, v42
v_lshl_or_b32 v22, v45, 16, v44
v_lshl_or_b32 v23, v47, 16, v46
v_lshl_or_b32 v24, v49, 16, v48
v_lshl_or_b32 v25, v51, 16, v50
v_lshl_or_b32 v26, v53, 16, v52
v_lshl_or_b32 v27, v55, 16, v54
v_lshl_or_b32 v28, v57, 16, v56
v_lshl_or_b32 v29, v59, 16, v58
v_lshl_or_b32 v30, v61, 16, v60
v_lshl_or_b32 v31, v63, 16, v62
v_cndmask_b32 v16, 0, v20, vcc
v_xor_b32 v20, v20, v16
v_cndmask_b32 v17, 0, v21, vcc
v_xor_b32 v21, v21, v17
v_cndmask_b32 v18, 0, v22, vcc
v_xor_b32 v22, v22, v18
v_cndmask_b32 v19, 0, v23, vcc
v_xor_b32 v23, v23, v19
v_lshlrev_b32 v32, 16, v70
v_and_b32 v33, 0xffff0000, v70
v_lshlrev_b32 v34, 16, v71
v_and_b32 v35, 0xffff0000, v71
buffer_store_dwordx4 v[16:19], v1, s[20:23], 0 offen offset:0
buffer_store_dwordx4 v[20:23], v1, s[20:23], 0 offen offset:1024
buffer_store_dwordx4 v[24:27], v1, s[20:23], 0 offen offset:2048
buffer_store_dwordx4 v[28:31], v1, s[20:23], 0 offen offset:3072
s_movk_i32 s3, 4096
buffer_store_dwordx4 v[32:35], v1, s[20:23], s3 offen
s_endpgm
.section .rodata,"a"
.p2align 6
.amdhsa_kernel part_kernel
  .amdhsa_next_free_vgpr 100
  .amdhsa_next_free_sgpr 56
  .amdhsa_accum_offset 100
  .amdhsa_group_segment_fixed_size 0
  .amdhsa_kernarg_size 112
  .amdhsa_user_sgpr_count 2
  .amdhsa_user_sgpr_kernarg_segment_ptr 1
  .amdhsa_system_sgpr_workgroup_id_x 1
.end_amdhsa_kernel
.text
.globl acc_kernel
.p2align 8
.type acc_kernel,@function
acc_kernel:
s_cmp_ge_u32 s2, 256
s_cbranch_scc1 K2_END
s_load_dwordx2 s[4:5], s[0:1], 104
s_load_dwordx2 s[12:13], s[0:1], 0
s_load_dwordx2 s[16:17], s[0:1], 88
s_load_dwordx2 s[88:89], s[0:1], 24
v_mov_b32 v160, 0
v_lshrrev_b32 v11, 6, v0
v_and_b32 v10, 63, v0
s_and_b32 s20, s2, 7
s_lshr_b32 s9, s2, 3
s_lshl_b32 s20, s20, 5
v_readfirstlane_b32 s3, v11
s_add_u32 s2, s20, s9
s_mul_i32 s20, s2, 2560
s_lshl_b32 s21, s3, 8
s_add_u32 s20, s20, s21
s_add_u32 s20, s20, 20480000
v_lshlrev_b32 v1, 3, v10
s_mov_b32 s6, 21140480
s_mov_b32 s7, 0x00020000
s_mov_b32 s18, 21135360
v_lshlrev_b32 v5, 4, v10
s_mul_i32 s22, s2, 625
s_lshl_b32 s21, s3, 6
s_add_u32 s22, s22, s21
v_and_b32 v14, 15, v0
v_bfe_u32 v12, v0, 4, 2
v_add_u32 v11, s22, v14
v_lshlrev_b32 v13, 3, v12
v_lshl_or_b32 v8, v11, 5, v13
v_lshlrev_b32 v11, 1, v11
s_mov_b32 s90, 320000
s_mov_b32 s91, 0x00020000
s_mov_b32 s19, 21139456
s_waitcnt lgkmcnt(0)
s_add_u32 s22, s4, s20
s_addc_u32 s23, s5, 0
s_load_dwordx16 s[24:39], s[22:23], 0
s_load_dwordx16 s[40:55], s[22:23], 64
s_load_dwordx16 s[56:71], s[22:23], 128
s_load_dwordx2 s[72:73], s[22:23], 192
buffer_load_dwordx4 v[48:51], v5, s[4:7], s18 offen offset:0
buffer_load_dwordx4 v[52:55], v5, s[4:7], s18 offen offset:1024
buffer_load_ushort v76, v11, s[88:91], 0 offen offset:0
buffer_load_ushort v78, v11, s[88:91], 0 offen offset:32
buffer_load_ushort v80, v11, s[88:91], 0 offen offset:64
buffer_load_ushort v82, v11, s[88:91], 0 offen offset:96
buffer_load_dwordx4 v[64:67], v5, s[4:7], s19 offen
s_mov_b64 exec, 33554431
buffer_load_dwordx2 v[136:137], v1, s[4:7], s20 offen
s_mov_b64 exec, -1
v_and_b32 v12, 0x78, v0
v_bfe_u32 v13, v0, 1, 2
v_and_b32 v11, 1, v0
v_lshl_or_b32 v12, v11, 2, v12
v_or_b32 v12, v12, v13
v_mul_u32_u24 v12, 1536, v12
v_add_u32 v11, 22272, v12
v_and_b32 v13, 127, v0
v_lshlrev_b32 v13, 2, v13
ds_write_b32 v13, v11 offset:0
s_mul_i32 s20, s3, 12288
s_add_u32 s20, s20, 22272
v_lshl_add_u32 v11, v10, 4, s20
v_mov_b32 v12, -1
v_mov_b32 v13, 0
v_mov_b32 v14, -1
v_mov_b32 v15, 0
ds_write_b128 v11, v[12:15]
s_mov_b32 s14, 5120000
s_mov_b32 s15, 0x00020000
v_mov_b32 v16, 0
v_mov_b32 v17, 0
v_mov_b32 v18, 0
v_mov_b32 v19, 0
v_mov_b32 v20, 0
v_mov_b32 v21, 0
v_mov_b32 v22, 0
v_mov_b32 v23, 0
v_mov_b32 v24, 0
v_mov_b32 v25, 0
v_mov_b32 v26, 0
v_mov_b32 v27, 0
v_mov_b32 v28, 0
v_mov_b32 v29, 0
v_mov_b32 v30, 0
v_mov_b32 v31, 0
v_mov_b32 v32, 0
v_mov_b32 v33, 0
v_mov_b32 v34, 0
v_mov_b32 v35, 0
v_mov_b32 v36, 0
v_mov_b32 v37, 0
v_mov_b32 v38, 0
v_mov_b32 v39, 0
v_mov_b32 v40, 0
v_mov_b32 v41, 0
v_mov_b32 v42, 0
v_mov_b32 v43, 0
v_mov_b32 v44, 0
v_mov_b32 v45, 0
v_mov_b32 v46, 0
v_mov_b32 v47, 0
v_and_b32 v3, 16, v0
v_mov_b32 v9, 8
v_mov_b32 v7, 0
v_and_b32 v12, 0x78, v10
v_bfe_u32 v13, v10, 1, 2
v_and_b32 v163, 1, v10
v_lshl_or_b32 v12, v163, 2, v12
v_or_b32 v12, v12, v13
v_mul_u32_u24 v12, 1536, v12
v_add_u32 v163, 23808, v12
v_mul_u32_u24 v11, 43, v10
v_bfe_u32 v12, v11, 8, 2
v_bfe_u32 v11, v11, 10, 1
s_lshl_b32 s21, s3, 5
v_lshlrev_b32 v12, 3, v12
v_lshl_or_b32 v12, v11, 2, v12
v_add_u32 v166, s21, v12
v_lshl_add_u32 v167, v10, 8, s20
s_mul_i32 s21, s3, 2176
s_add_u32 s21, s21, 512
v_and_b32 v14, 15, v0
v_bfe_u32 v12, v0, 5, 1
v_lshlrev_b32 v11, 3, v14
v_lshl_or_b32 v11, v12, 7, v11
v_add_u32 v4, s20, v11
v_lshl_add_u32 v5, v10, 4, s21
ds_write_b128 v5, v[16:19]
ds_write_b128 v5, v[16:19] offset:1088
v_bfe_u32 v11, v0, 2, 2
v_lshlrev_b32 v11, 8, v11
v_lshl_or_b32 v11, v12, 3, v11
v_and_b32 v13, 3, v0
v_lshl_or_b32 v11, v13, 1, v11
v_mul_u32_u24 v13, 68, v3
v_add3_u32 v2, v11, v13, s21
v_lshlrev_b32 v13, 19, v3
v_add_u32 v6, 0x3e22f983, v13
v_lshlrev_b32 v164, 2, v10
v_lshlrev_b32 v165, 1, v10
s_add_u32 s92, s4, 10240000
s_addc_u32 s93, s5, 0
s_mov_b32 s94, 5120000
s_mov_b32 s95, 0x00020000
s_mul_i32 s9, s9, 10
s_add_u32 s9, s9, s3
s_lshl_b32 s74, s9, 13
s_movk_i32 s101, 1024
s_mov_b32 s87, 0
s_waitcnt lgkmcnt(0)
s_barrier
s_cmp_lt_u32 s3, 5
s_cbranch_scc1 K2_R0
s_waitcnt vmcnt(0)
s_call_b64 s[76:77], K2_RBF
K2_R0:
s_min_u32 s6, s25, 10240000
buffer_load_dword v84, v164, s[4:7], s24 offen
s_lshr_b32 s21, s24, 1
buffer_load_ushort v85, v165, s[92:95], s21 offen
s_min_u32 s6, s27, 10240000
buffer_load_dword v86, v164, s[4:7], s26 offen
s_lshr_b32 s21, s26, 1
buffer_load_ushort v87, v165, s[92:95], s21 offen
s_min_u32 s6, s29, 10240000
buffer_load_dword v88, v164, s[4:7], s28 offen
s_lshr_b32 s21, s28, 1
buffer_load_ushort v89, v165, s[92:95], s21 offen
s_min_u32 s6, s31, 10240000
buffer_load_dword v90, v164, s[4:7], s30 offen
s_lshr_b32 s21, s30, 1
buffer_load_ushort v91, v165, s[92:95], s21 offen
s_min_u32 s6, s33, 10240000
buffer_load_dword v92, v164, s[4:7], s32 offen
s_lshr_b32 s21, s32, 1
buffer_load_ushort v93, v165, s[92:95], s21 offen
s_min_u32 s6, s35, 10240000
buffer_load_dword v94, v164, s[4:7], s34 offen
s_lshr_b32 s21, s34, 1
buffer_load_ushort v95, v165, s[92:95], s21 offen
s_min_u32 s6, s37, 10240000
buffer_load_dword v96, v164, s[4:7], s36 offen
s_lshr_b32 s21, s36, 1
buffer_load_ushort v97, v165, s[92:95], s21 offen
s_min_u32 s6, s39, 10240000
buffer_load_dword v98, v164, s[4:7], s38 offen
s_lshr_b32 s21, s38, 1
buffer_load_ushort v99, v165, s[92:95], s21 offen
s_min_u32 s6, s41, 10240000
buffer_load_dword v100, v164, s[4:7], s40 offen
s_lshr_b32 s21, s40, 1
buffer_load_ushort v101, v165, s[92:95], s21 offen
s_min_u32 s6, s43, 10240000
buffer_load_dword v102, v164, s[4:7], s42 offen
s_lshr_b32 s21, s42, 1
buffer_load_ushort v103, v165, s[92:95], s21 offen
s_min_u32 s6, s45, 10240000
buffer_load_dword v104, v164, s[4:7], s44 offen
s_lshr_b32 s21, s44, 1
buffer_load_ushort v105, v165, s[92:95], s21 offen
s_min_u32 s6, s47, 10240000
buffer_load_dword v106, v164, s[4:7], s46 offen
s_lshr_b32 s21, s46, 1
buffer_load_ushort v107, v165, s[92:95], s21 offen
s_min_u32 s6, s49, 10240000
buffer_load_dword v108, v164, s[4:7], s48 offen
s_lshr_b32 s21, s48, 1
buffer_load_ushort v109, v165, s[92:95], s21 offen
s_min_u32 s6, s51, 10240000
buffer_load_dword v110, v164, s[4:7], s50 offen
s_lshr_b32 s21, s50, 1
buffer_load_ushort v111, v165, s[92:95], s21 offen
s_min_u32 s6, s53, 10240000
buffer_load_dword v112, v164, s[4:7], s52 offen
s_lshr_b32 s21, s52, 1
buffer_load_ushort v113, v165, s[92:95], s21 offen
s_min_u32 s6, s55, 10240000
buffer_load_dword v114, v164, s[4:7], s54 offen
s_lshr_b32 s21, s54, 1
buffer_load_ushort v115, v165, s[92:95], s21 offen
s_min_u32 s6, s57, 10240000
buffer_load_dword v116, v164, s[4:7], s56 offen
s_lshr_b32 s21, s56, 1
buffer_load_ushort v117, v165, s[92:95], s21 offen
s_min_u32 s6, s59, 10240000
buffer_load_dword v118, v164, s[4:7], s58 offen
s_lshr_b32 s21, s58, 1
buffer_load_ushort v119, v165, s[92:95], s21 offen
s_min_u32 s6, s61, 10240000
buffer_load_dword v120, v164, s[4:7], s60 offen
s_lshr_b32 s21, s60, 1
buffer_load_ushort v121, v165, s[92:95], s21 offen
s_min_u32 s6, s63, 10240000
buffer_load_dword v122, v164, s[4:7], s62 offen
s_lshr_b32 s21, s62, 1
buffer_load_ushort v123, v165, s[92:95], s21 offen
s_min_u32 s6, s65, 10240000
buffer_load_dword v124, v164, s[4:7], s64 offen
s_lshr_b32 s21, s64, 1
buffer_load_ushort v125, v165, s[92:95], s21 offen
s_min_u32 s6, s67, 10240000
buffer_load_dword v126, v164, s[4:7], s66 offen
s_lshr_b32 s21, s66, 1
buffer_load_ushort v127, v165, s[92:95], s21 offen
s_min_u32 s6, s69, 10240000
buffer_load_dword v128, v164, s[4:7], s68 offen
s_lshr_b32 s21, s68, 1
buffer_load_ushort v129, v165, s[92:95], s21 offen
s_min_u32 s6, s71, 10240000
buffer_load_dword v130, v164, s[4:7], s70 offen
s_lshr_b32 s21, s70, 1
buffer_load_ushort v131, v165, s[92:95], s21 offen
s_min_u32 s6, s73, 10240000
buffer_load_dword v132, v164, s[4:7], s72 offen
s_lshr_b32 s21, s72, 1
buffer_load_ushort v133, v165, s[92:95], s21 offen
s_waitcnt vmcnt(50)
v_sub_u32 v136, v137, v136
v_cmp_lt_u32 vcc, 256, v136
s_movk_i32 s8, 256
s_mov_b32 s6, 0
s_mov_b32 s20, 0
s_and_b32 s100, vcc_lo, 33554431
s_mov_b32 s75, s100
s_cbranch_scc0 K2_X0
s_ff1_i32_b32 s22, s100
s_lshl_b32 m0, s22, 1
s_nop 0
s_movrels_b64 s[20:21], s[24:25]
s_add_u32 s20, s20, s8
s_min_u32 s6, s21, 10240000
s_add_u32 s8, s8, 256
s_add_u32 s23, s20, 256
s_cmp_lt_u32 s23, s6
s_cbranch_scc1 K2_X0
s_bitset0_b32 s100, s22
s_movk_i32 s8, 256
K2_X0:
buffer_load_dword v134, v164, s[4:7], s20 offen
s_lshr_b32 s21, s20, 1
buffer_load_ushort v135, v165, s[92:95], s21 offen
s_waitcnt vmcnt(43)
v_cmp_ne_u32 s[76:77], 0, v84
v_lshrrev_b32 v136, 23, v84
v_cmp_ne_u32 s[78:79], 0, v86
v_lshrrev_b32 v137, 23, v86
v_cmp_ne_u32 s[80:81], 0, v88
v_lshrrev_b32 v138, 23, v88
v_cmp_ne_u32 s[82:83], 0, v90
v_lshrrev_b32 v139, 23, v90
v_cmp_ne_u32 s[84:85], 0, v92
v_lshrrev_b32 v140, 23, v92
s_mov_b64 exec, s[76:77]
ds_add_rtn_u32 v136, v136, v9 offset:0
s_mov_b64 exec, s[78:79]
ds_add_rtn_u32 v137, v137, v9 offset:0
s_mov_b64 exec, s[80:81]
ds_add_rtn_u32 v138, v138, v9 offset:0
s_mov_b64 exec, s[82:83]
ds_add_rtn_u32 v139, v139, v9 offset:0
s_mov_b64 exec, s[84:85]
ds_add_rtn_u32 v140, v140, v9 offset:0
s_waitcnt vmcnt(33)
s_mov_b64 exec, -1
v_cmp_ne_u32 s[10:11], 0, v94
v_lshrrev_b32 v141, 23, v94
v_cmp_ne_u32 s[22:23], 0, v96
v_lshrrev_b32 v142, 23, v96
v_cmp_ne_u32 s[90:91], 0, v98
v_lshrrev_b32 v143, 23, v98
v_cmp_ne_u32 s[96:97], 0, v100
v_lshrrev_b32 v144, 23, v100
v_cmp_ne_u32 s[98:99], 0, v102
v_lshrrev_b32 v145, 23, v102
s_mov_b64 exec, s[10:11]
ds_add_rtn_u32 v141, v141, v9 offset:0
s_mov_b64 exec, s[22:23]
ds_add_rtn_u32 v142, v142, v9 offset:0
s_mov_b64 exec, s[90:91]
ds_add_rtn_u32 v143, v143, v9 offset:0
s_mov_b64 exec, s[96:97]
ds_add_rtn_u32 v144, v144, v9 offset:0
s_mov_b64 exec, s[98:99]
ds_add_rtn_u32 v145, v145, v9 offset:0
s_mov_b64 exec, s[76:77]
s_waitcnt lgkmcnt(9)
v_min_u32 v136, 145144, v136
ds_write_b64 v136, v[84:85]
s_mov_b64 exec, s[78:79]
s_waitcnt lgkmcnt(9)
v_min_u32 v137, 145144, v137
ds_write_b64 v137, v[86:87]
s_mov_b64 exec, s[80:81]
s_waitcnt lgkmcnt(9)
v_min_u32 v138, 145144, v138
ds_write_b64 v138, v[88:89]
s_mov_b64 exec, s[82:83]
s_waitcnt lgkmcnt(9)
v_min_u32 v139, 145144, v139
ds_write_b64 v139, v[90:91]
s_mov_b64 exec, s[84:85]
s_waitcnt lgkmcnt(9)
v_min_u32 v140, 145144, v140
ds_write_b64 v140, v[92:93]
s_waitcnt vmcnt(23)
s_mov_b64 exec, -1
v_cmp_ne_u32 s[76:77], 0, v104
v_lshrrev_b32 v136, 23, v104
v_cmp_ne_u32 s[78:79], 0, v106
v_lshrrev_b32 v137, 23, v106
v_cmp_ne_u32 s[80:81], 0, v108
v_lshrrev_b32 v138, 23, v108
v_cmp_ne_u32 s[82:83], 0, v110
v_lshrrev_b32 v139, 23, v110
v_cmp_ne_u32 s[84:85], 0, v112
v_lshrrev_b32 v140, 23, v112
s_mov_b64 exec, s[76:77]
ds_add_rtn_u32 v136, v136, v9 offset:0
s_mov_b64 exec, s[78:79]
ds_add_rtn_u32 v137, v137, v9 offset:0
s_mov_b64 exec, s[80:81]
ds_add_rtn_u32 v138, v138, v9 offset:0
s_mov_b64 exec, s[82:83]
ds_add_rtn_u32 v139, v139, v9 offset:0
s_mov_b64 exec, s[84:85]
ds_add_rtn_u32 v140, v140, v9 offset:0
s_mov_b64 exec, s[10:11]
s_waitcnt lgkmcnt(14)
v_min_u32 v141, 145144, v141
ds_write_b64 v141, v[94:95]
s_mov_b64 exec, s[22:23]
s_waitcnt lgkmcnt(14)
v_min_u32 v142, 145144, v142
ds_write_b64 v142, v[96:97]
s_mov_b64 exec, s[90:91]
s_waitcnt lgkmcnt(14)
v_min_u32 v143, 145144, v143
ds_write_b64 v143, v[98:99]
s_mov_b64 exec, s[96:97]
s_waitcnt lgkmcnt(14)
v_min_u32 v144, 145144, v144
ds_write_b64 v144, v[100:101]
s_mov_b64 exec, s[98:99]
s_waitcnt lgkmcnt(14)
v_min_u32 v145, 145144, v145
ds_write_b64 v145, v[102:103]
s_waitcnt vmcnt(13)
s_mov_b64 exec, -1
v_cmp_ne_u32 s[10:11], 0, v114
v_lshrrev_b32 v141, 23, v114
v_cmp_ne_u32 s[22:23], 0, v116
v_lshrrev_b32 v142, 23, v116
v_cmp_ne_u32 s[90:91], 0, v118
v_lshrrev_b32 v143, 23, v118
v_cmp_ne_u32 s[96:97], 0, v120
v_lshrrev_b32 v144, 23, v120
v_cmp_ne_u32 s[98:99], 0, v122
v_lshrrev_b32 v145, 23, v122
s_mov_b64 exec, s[10:11]
ds_add_rtn_u32 v141, v141, v9 offset:0
s_mov_b64 exec, s[22:23]
ds_add_rtn_u32 v142, v142, v9 offset:0
s_mov_b64 exec, s[90:91]
ds_add_rtn_u32 v143, v143, v9 offset:0
s_mov_b64 exec, s[96:97]
ds_add_rtn_u32 v144, v144, v9 offset:0
s_mov_b64 exec, s[98:99]
ds_add_rtn_u32 v145, v145, v9 offset:0
s_mov_b64 exec, s[76:77]
s_waitcnt lgkmcnt(14)
v_min_u32 v136, 145144, v136
ds_write_b64 v136, v[104:105]
s_mov_b64 exec, s[78:79]
s_waitcnt lgkmcnt(14)
v_min_u32 v137, 145144, v137
ds_write_b64 v137, v[106:107]
s_mov_b64 exec, s[80:81]
s_waitcnt lgkmcnt(14)
v_min_u32 v138, 145144, v138
ds_write_b64 v138, v[108:109]
s_mov_b64 exec, s[82:83]
s_waitcnt lgkmcnt(14)
v_min_u32 v139, 145144, v139
ds_write_b64 v139, v[110:111]
s_mov_b64 exec, s[84:85]
s_waitcnt lgkmcnt(14)
v_min_u32 v140, 145144, v140
ds_write_b64 v140, v[112:113]
s_waitcnt vmcnt(3)
s_mov_b64 exec, -1
v_cmp_ne_u32 s[76:77], 0, v124
v_lshrrev_b32 v136, 23, v124
v_cmp_ne_u32 s[78:79], 0, v126
v_lshrrev_b32 v137, 23, v126
v_cmp_ne_u32 s[80:81], 0, v128
v_lshrrev_b32 v138, 23, v128
v_cmp_ne_u32 s[82:83], 0, v130
v_lshrrev_b32 v139, 23, v130
v_cmp_ne_u32 s[84:85], 0, v132
v_lshrrev_b32 v140, 23, v132
s_mov_b64 exec, s[76:77]
ds_add_rtn_u32 v136, v136, v9 offset:0
s_mov_b64 exec, s[78:79]
ds_add_rtn_u32 v137, v137, v9 offset:0
s_mov_b64 exec, s[80:81]
ds_add_rtn_u32 v138, v138, v9 offset:0
s_mov_b64 exec, s[82:83]
ds_add_rtn_u32 v139, v139, v9 offset:0
s_mov_b64 exec, s[84:85]
ds_add_rtn_u32 v140, v140, v9 offset:0
s_mov_b64 exec, s[10:11]
s_waitcnt lgkmcnt(14)
v_min_u32 v141, 145144, v141
ds_write_b64 v141, v[114:115]
s_mov_b64 exec, s[22:23]
s_waitcnt lgkmcnt(14)
v_min_u32 v142, 145144, v142
ds_write_b64 v142, v[116:117]
s_mov_b64 exec, s[90:91]
s_waitcnt lgkmcnt(14)
v_min_u32 v143, 145144, v143
ds_write_b64 v143, v[118:119]
s_mov_b64 exec, s[96:97]
s_waitcnt lgkmcnt(14)
v_min_u32 v144, 145144, v144
ds_write_b64 v144, v[120:121]
s_mov_b64 exec, s[98:99]
s_waitcnt lgkmcnt(14)
v_min_u32 v145, 145144, v145
ds_write_b64 v145, v[122:123]
s_waitcnt vmcnt(0)
s_mov_b64 exec, s[76:77]
s_waitcnt lgkmcnt(9)
v_min_u32 v136, 145144, v136
ds_write_b64 v136, v[124:125]
s_mov_b64 exec, s[78:79]
s_waitcnt lgkmcnt(9)
v_min_u32 v137, 145144, v137
ds_write_b64 v137, v[126:127]
s_mov_b64 exec, s[80:81]
s_waitcnt lgkmcnt(9)
v_min_u32 v138, 145144, v138
ds_write_b64 v138, v[128:129]
s_mov_b64 exec, s[82:83]
s_waitcnt lgkmcnt(9)
v_min_u32 v139, 145144, v139
ds_write_b64 v139, v[130:131]
s_mov_b64 exec, s[84:85]
s_waitcnt lgkmcnt(9)
v_min_u32 v140, 145144, v140
ds_write_b64 v140, v[132:133]
s_mov_b64 exec, -1
s_cmp_eq_u32 s75, 0
s_cbranch_scc1 K2_XD
K2_XL:
s_waitcnt vmcnt(0)
v_cmpx_ne_u32 vcc, 0, v134
v_lshrrev_b32 v146, 23, v134
ds_add_rtn_u32 v146, v146, v9 offset:0
s_waitcnt lgkmcnt(0)
v_min_u32 v146, 145144, v146
ds_write_b64 v146, v[134:135]
s_mov_b64 exec, -1
s_cmp_eq_u32 s100, 0
s_cbranch_scc1 K2_XD
s_ff1_i32_b32 s22, s100
s_lshl_b32 m0, s22, 1
s_nop 0
s_movrels_b64 s[20:21], s[24:25]
s_add_u32 s20, s20, s8
s_min_u32 s6, s21, 10240000
s_add_u32 s8, s8, 256
s_add_u32 s23, s20, 256
s_cmp_lt_u32 s23, s6
s_cbranch_scc1 K2_X1
s_bitset0_b32 s100, s22
s_movk_i32 s8, 256
K2_X1:
s_waitcnt lgkmcnt(0)
buffer_load_dword v134, v164, s[4:7], s20 offen
s_lshr_b32 s21, s20, 1
buffer_load_ushort v135, v165, s[92:95], s21 offen
s_branch K2_XL
K2_XD:
s_mov_b32 s6, 21140480
s_mov_b32 s18, 21135360
v_lshlrev_b32 v11, 4, v10
buffer_load_dwordx4 v[56:59], v11, s[4:7], s18 offen offset:2048
buffer_load_dwordx4 v[60:63], v11, s[4:7], s18 offen offset:3072
buffer_load_dwordx2 v[68:69], v8, s[12:15], 0 offen offset:0
buffer_load_dwordx2 v[70:71], v8, s[12:15], 0 offen offset:512
buffer_load_dwordx2 v[72:73], v8, s[12:15], 0 offen offset:1024
buffer_load_dwordx2 v[74:75], v8, s[12:15], 0 offen offset:1536
s_add_u32 s18, s2, 1
s_mul_i32 s18, s18, 20000
s_mov_b32 s19, 0x00020000
s_cmp_ge_u32 s3, 5
s_cbranch_scc1 K2_R1
s_call_b64 s[76:77], K2_RBF
K2_R1:
K2_COMMON:
s_waitcnt lgkmcnt(0)
s_barrier
s_mov_b32 s30, 0x7fffe0
ds_read_b64 v[142:143], v4 offset:0
ds_read_b64 v[144:145], v4 offset:256
ds_read_b64 v[158:159], v4 offset:512
ds_read_b32 v12, v166 offset:0
ds_read_b32 v13, v164 offset:0
ds_read_b32 v14, v164 offset:256
s_lshl_b32 s20, s3, 5
v_lshrrev_b32 v15, 5, v10
v_lshl_add_u32 v15, v15, 2, s20
ds_read_b32 v136, v15 offset:0
ds_read_b32 v137, v15 offset:8
ds_read_b32 v138, v15 offset:16
ds_read_b32 v139, v15 offset:24
s_mov_b32 s32, 0
v_add_u32 v15, 98304, v163
s_waitcnt lgkmcnt(9)
v_lshlrev_b32 v143, 16, v143
v_mul_f32 v143, v6, v143
v_fract_f32 v143, v143
v_cos_f32 v143, v143
v_and_or_b32 v11, v142, s30, v3
v_cvt_pk_bf16_f32 v96, v143, v143
v_lshlrev_b32_sdwa v96, 4, v142 dst_sel:BYTE_0 dst_unused:UNUSED_PRESERVE src0_sel:DWORD src1_sel:DWORD
buffer_load_dwordx4 v[84:87], v11, s[12:15], 0 offen
s_waitcnt lgkmcnt(8)
v_lshlrev_b32 v145, 16, v145
v_mul_f32 v145, v6, v145
v_fract_f32 v145, v145
v_cos_f32 v145, v145
v_and_or_b32 v11, v144, s30, v3
v_cvt_pk_bf16_f32 v97, v145, v145
v_lshlrev_b32_sdwa v97, 4, v144 dst_sel:BYTE_0 dst_unused:UNUSED_PRESERVE src0_sel:DWORD src1_sel:DWORD
buffer_load_dwordx4 v[88:91], v11, s[12:15], 0 offen
s_waitcnt lgkmcnt(0)
v_cmp_gt_u32 vcc, v13, v163
v_cmp_gt_u32 s[20:21], v14, v15
v_cmp_lt_u32 s[26:27], v167, v12
v_add_u32_sdwa v161, v96, v2 dst_sel:DWORD dst_unused:UNUSED_PAD src0_sel:BYTE_0 src1_sel:DWORD
ds_write_b16_d16_hi v161, v96
ds_read_b128 v[150:153], v5
ds_read_b128 v[154:157], v5 offset:1088
ds_write_b16 v161, v7
s_or_b64 vcc, vcc, s[20:21]
s_cbranch_vccnz K2_SLOWINIT
v_and_b32 v11, 0xf8, v1
v_mov_b32 v14, -1
v_mov_b32 v15, 0
v_add_u32 v12, 255, v136
v_add_u32 v13, v11, v136
v_and_b32 v12, 0xffffff00, v12
v_cmpx_lt_u32 vcc, v13, v12
ds_write_b64 v13, v[14:15]
s_mov_b64 exec, -1
v_add_u32 v12, 255, v137
v_add_u32 v13, v11, v137
v_and_b32 v12, 0xffffff00, v12
v_cmpx_lt_u32 vcc, v13, v12
ds_write_b64 v13, v[14:15]
s_mov_b64 exec, -1
v_add_u32 v12, 255, v138
v_add_u32 v13, v11, v138
v_and_b32 v12, 0xffffff00, v12
v_cmpx_lt_u32 vcc, v13, v12
ds_write_b64 v13, v[14:15]
s_mov_b64 exec, -1
v_add_u32 v12, 255, v139
v_add_u32 v13, v11, v139
v_and_b32 v12, 0xffffff00, v12
v_cmpx_lt_u32 vcc, v13, v12
ds_write_b64 v13, v[14:15]
s_mov_b64 exec, -1
s_or_b32 s26, s26, 7
s_and_b32 s27, s27, 0xffff
s_lshr_b64 s[28:29], s[26:27], 1
s_andn2_b32 s24, s26, 7
s_mov_b32 s25, s27
s_andn2_b32 s28, s28, 545392672
s_andn2_b32 s29, s29, 33288
s_andn2_b64 s[28:29], s[26:27], s[28:29]
v_mov_b32 v134, 0
v_mov_b32 v135, 0
v_mov_b32 v136, 0
v_mov_b32 v137, 0
v_mov_b32 v138, 0
v_mov_b32 v139, 0
v_mov_b32 v140, 0
v_mov_b32 v141, 0
v_lshlrev_b32 v159, 16, v159
v_mul_f32 v159, v6, v159
v_fract_f32 v159, v159
v_cos_f32 v159, v159
v_and_or_b32 v162, v158, s30, v3
v_cvt_pk_bf16_f32 v98, v159, v159
v_lshlrev_b32_sdwa v98, 4, v158 dst_sel:BYTE_0 dst_unused:UNUSED_PRESERVE src0_sel:DWORD src1_sel:DWORD
K2_LOOP:
s_cmp_ge_i32 s32, 0
s_cselect_b64 exec, -1, 1
s_waitcnt vmcnt(1)
buffer_load_dwordx4 v[92:95], v162, s[12:15], 0 offen
s_mov_b64 exec, -1
v_mfma_f32_16x16x32_bf16 v[142:145], v[84:87], v[48:51], 0
v_mfma_f32_16x16x32_bf16 v[146:149], v[84:87], v[52:55], 0
s_ff1_i32_b64 s32, s[24:25]
s_bitset0_b64 s[24:25], s32
v_lshl_add_u32 v11, s32, 8, v4
ds_read_b64 v[158:159], v11
s_ff1_i32_b64 s33, s[26:27]
s_bitset0_b64 s[26:27], s33
s_nop 0
v_cvt_pk_bf16_f32 v12, v142, v143
v_cvt_pk_bf16_f32 v13, v144, v145
v_cvt_pk_bf16_f32 v14, v146, v147
v_cvt_pk_bf16_f32 v15, v148, v149
s_bitcmp1_b64 s[28:29], s33
s_waitcnt lgkmcnt(2)
v_mfma_f32_16x16x32_bf16 v[134:137], v[12:15], v[150:153], v[134:137]
v_mfma_f32_16x16x32_bf16 v[138:141], v[12:15], v[154:157], v[138:141]
v_add_u32_sdwa v161, v97, v2 dst_sel:DWORD dst_unused:UNUSED_PAD src0_sel:BYTE_0 src1_sel:DWORD
ds_write_b16_d16_hi v161, v97
ds_read_b128 v[150:153], v5
ds_read_b128 v[154:157], v5 offset:1088
ds_write_b16 v161, v7
s_waitcnt lgkmcnt(4)
v_lshlrev_b32 v159, 16, v159
v_mul_f32 v159, v6, v159
v_fract_f32 v159, v159
v_cos_f32 v159, v159
v_and_or_b32 v162, v158, s30, v3
v_cvt_pk_bf16_f32 v96, v159, v159
v_lshlrev_b32_sdwa v96, 4, v158 dst_sel:BYTE_0 dst_unused:UNUSED_PRESERVE src0_sel:DWORD src1_sel:DWORD
s_cbranch_scc0 K2_N0
s_call_b64 s[34:35], K2_FLUSH
s_cbranch_scc1 K2_MDONE
K2_N0:
s_cmp_ge_i32 s32, 0
s_cselect_b64 exec, -1, 1
s_waitcnt vmcnt(1)
buffer_load_dwordx4 v[84:87], v162, s[12:15], 0 offen
s_mov_b64 exec, -1
v_mfma_f32_16x16x32_bf16 v[142:145], v[88:91], v[48:51], 0
v_mfma_f32_16x16x32_bf16 v[146:149], v[88:91], v[52:55], 0
s_ff1_i32_b64 s32, s[24:25]
s_bitset0_b64 s[24:25], s32
v_lshl_add_u32 v11, s32, 8, v4
ds_read_b64 v[158:159], v11
s_ff1_i32_b64 s33, s[26:27]
s_bitset0_b64 s[26:27], s33
s_nop 0
v_cvt_pk_bf16_f32 v12, v142, v143
v_cvt_pk_bf16_f32 v13, v144, v145
v_cvt_pk_bf16_f32 v14, v146, v147
v_cvt_pk_bf16_f32 v15, v148, v149
s_bitcmp1_b64 s[28:29], s33
s_waitcnt lgkmcnt(2)
v_mfma_f32_16x16x32_bf16 v[134:137], v[12:15], v[150:153], v[134:137]
v_mfma_f32_16x16x32_bf16 v[138:141], v[12:15], v[154:157], v[138:141]
v_add_u32_sdwa v161, v98, v2 dst_sel:DWORD dst_unused:UNUSED_PAD src0_sel:BYTE_0 src1_sel:DWORD
ds_write_b16_d16_hi v161, v98
ds_read_b128 v[150:153], v5
ds_read_b128 v[154:157], v5 offset:1088
ds_write_b16 v161, v7
s_waitcnt lgkmcnt(4)
v_lshlrev_b32 v159, 16, v159
v_mul_f32 v159, v6, v159
v_fract_f32 v159, v159
v_cos_f32 v159, v159
v_and_or_b32 v162, v158, s30, v3
v_cvt_pk_bf16_f32 v97, v159, v159
v_lshlrev_b32_sdwa v97, 4, v158 dst_sel:BYTE_0 dst_unused:UNUSED_PRESERVE src0_sel:DWORD src1_sel:DWORD
s_cbranch_scc0 K2_N1
s_call_b64 s[34:35], K2_FLUSH
s_cbranch_scc1 K2_MDONE
K2_N1:
s_cmp_ge_i32 s32, 0
s_cselect_b64 exec, -1, 1
s_waitcnt vmcnt(1)
buffer_load_dwordx4 v[88:91], v162, s[12:15], 0 offen
s_mov_b64 exec, -1
v_mfma_f32_16x16x32_bf16 v[142:145], v[92:95], v[48:51], 0
v_mfma_f32_16x16x32_bf16 v[146:149], v[92:95], v[52:55], 0
s_ff1_i32_b64 s32, s[24:25]
s_bitset0_b64 s[24:25], s32
v_lshl_add_u32 v11, s32, 8, v4
ds_read_b64 v[158:159], v11
s_ff1_i32_b64 s33, s[26:27]
s_bitset0_b64 s[26:27], s33
s_nop 0
v_cvt_pk_bf16_f32 v12, v142, v143
v_cvt_pk_bf16_f32 v13, v144, v145
v_cvt_pk_bf16_f32 v14, v146, v147
v_cvt_pk_bf16_f32 v15, v148, v149
s_bitcmp1_b64 s[28:29], s33
s_waitcnt lgkmcnt(2)
v_mfma_f32_16x16x32_bf16 v[134:137], v[12:15], v[150:153], v[134:137]
v_mfma_f32_16x16x32_bf16 v[138:141], v[12:15], v[154:157], v[138:141]
v_add_u32_sdwa v161, v96, v2 dst_sel:DWORD dst_unused:UNUSED_PAD src0_sel:BYTE_0 src1_sel:DWORD
ds_write_b16_d16_hi v161, v96
ds_read_b128 v[150:153], v5
ds_read_b128 v[154:157], v5 offset:1088
ds_write_b16 v161, v7
s_waitcnt lgkmcnt(4)
v_lshlrev_b32 v159, 16, v159
v_mul_f32 v159, v6, v159
v_fract_f32 v159, v159
v_cos_f32 v159, v159
v_and_or_b32 v162, v158, s30, v3
v_cvt_pk_bf16_f32 v98, v159, v159
v_lshlrev_b32_sdwa v98, 4, v158 dst_sel:BYTE_0 dst_unused:UNUSED_PRESERVE src0_sel:DWORD src1_sel:DWORD
s_cbranch_scc0 K2_LOOP
s_call_b64 s[34:35], K2_FLUSH
s_cbranch_scc0 K2_LOOP
s_branch K2_MDONE
K2_RBF:
v_lshlrev_b32 v76, 16, v76
v_sub_f32 v150, v76, v64
v_sub_f32 v151, v76, v65
v_sub_f32 v152, v76, v66
v_sub_f32 v153, v76, v67
v_cvt_pk_bf16_f32 v154, v150, v151
v_lshlrev_b32 v150, 16, v154
v_and_b32 v151, 0xffff0000, v154
v_cvt_pk_bf16_f32 v154, v152, v153
v_lshlrev_b32 v152, 16, v154
v_and_b32 v153, 0xffff0000, v154
v_mul_f32 v150, v150, v150
v_mul_f32 v151, v151, v151
v_mul_f32 v152, v152, v152
v_mul_f32 v153, v153, v153
v_cvt_pk_bf16_f32 v154, v150, v151
v_lshlrev_b32 v150, 16, v154
v_and_b32 v151, 0xffff0000, v154
v_cvt_pk_bf16_f32 v154, v152, v153
v_lshlrev_b32 v152, 16, v154
v_and_b32 v153, 0xffff0000, v154
v_mul_f32 v150, 0xc1200000, v150
v_mul_f32 v151, 0xc1200000, v151
v_mul_f32 v152, 0xc1200000, v152
v_mul_f32 v153, 0xc1200000, v153
v_cvt_pk_bf16_f32 v154, v150, v151
v_lshlrev_b32 v150, 16, v154
v_and_b32 v151, 0xffff0000, v154
v_cvt_pk_bf16_f32 v154, v152, v153
v_lshlrev_b32 v152, 16, v154
v_and_b32 v153, 0xffff0000, v154
v_mul_f32 v150, 0x3fb8aa3b, v150
v_mul_f32 v151, 0x3fb8aa3b, v151
v_mul_f32 v152, 0x3fb8aa3b, v152
v_mul_f32 v153, 0x3fb8aa3b, v153
v_exp_f32 v150, v150
v_exp_f32 v151, v151
v_exp_f32 v152, v152
v_exp_f32 v153, v153
s_nop 0
v_cvt_pk_bf16_f32 v76, v150, v151
v_cvt_pk_bf16_f32 v77, v152, v153
v_lshlrev_b32 v78, 16, v78
v_sub_f32 v150, v78, v64
v_sub_f32 v151, v78, v65
v_sub_f32 v152, v78, v66
v_sub_f32 v153, v78, v67
v_cvt_pk_bf16_f32 v154, v150, v151
v_lshlrev_b32 v150, 16, v154
v_and_b32 v151, 0xffff0000, v154
v_cvt_pk_bf16_f32 v154, v152, v153
v_lshlrev_b32 v152, 16, v154
v_and_b32 v153, 0xffff0000, v154
v_mul_f32 v150, v150, v150
v_mul_f32 v151, v151, v151
v_mul_f32 v152, v152, v152
v_mul_f32 v153, v153, v153
v_cvt_pk_bf16_f32 v154, v150, v151
v_lshlrev_b32 v150, 16, v154
v_and_b32 v151, 0xffff0000, v154
v_cvt_pk_bf16_f32 v154, v152, v153
v_lshlrev_b32 v152, 16, v154
v_and_b32 v153, 0xffff0000, v154
v_mul_f32 v150, 0xc1200000, v150
v_mul_f32 v151, 0xc1200000, v151
v_mul_f32 v152, 0xc1200000, v152
v_mul_f32 v153, 0xc1200000, v153
v_cvt_pk_bf16_f32 v154, v150, v151
v_lshlrev_b32 v150, 16, v154
v_and_b32 v151, 0xffff0000, v154
v_cvt_pk_bf16_f32 v154, v152, v153
v_lshlrev_b32 v152, 16, v154
v_and_b32 v153, 0xffff0000, v154
v_mul_f32 v150, 0x3fb8aa3b, v150
v_mul_f32 v151, 0x3fb8aa3b, v151
v_mul_f32 v152, 0x3fb8aa3b, v152
v_mul_f32 v153, 0x3fb8aa3b, v153
v_exp_f32 v150, v150
v_exp_f32 v151, v151
v_exp_f32 v152, v152
v_exp_f32 v153, v153
s_nop 0
v_cvt_pk_bf16_f32 v78, v150, v151
v_cvt_pk_bf16_f32 v79, v152, v153
v_lshlrev_b32 v80, 16, v80
v_sub_f32 v150, v80, v64
v_sub_f32 v151, v80, v65
v_sub_f32 v152, v80, v66
v_sub_f32 v153, v80, v67
v_cvt_pk_bf16_f32 v154, v150, v151
v_lshlrev_b32 v150, 16, v154
v_and_b32 v151, 0xffff0000, v154
v_cvt_pk_bf16_f32 v154, v152, v153
v_lshlrev_b32 v152, 16, v154
v_and_b32 v153, 0xffff0000, v154
v_mul_f32 v150, v150, v150
v_mul_f32 v151, v151, v151
v_mul_f32 v152, v152, v152
v_mul_f32 v153, v153, v153
v_cvt_pk_bf16_f32 v154, v150, v151
v_lshlrev_b32 v150, 16, v154
v_and_b32 v151, 0xffff0000, v154
v_cvt_pk_bf16_f32 v154, v152, v153
v_lshlrev_b32 v152, 16, v154
v_and_b32 v153, 0xffff0000, v154
v_mul_f32 v150, 0xc1200000, v150
v_mul_f32 v151, 0xc1200000, v151
v_mul_f32 v152, 0xc1200000, v152
v_mul_f32 v153, 0xc1200000, v153
v_cvt_pk_bf16_f32 v154, v150, v151
v_lshlrev_b32 v150, 16, v154
v_and_b32 v151, 0xffff0000, v154
v_cvt_pk_bf16_f32 v154, v152, v153
v_lshlrev_b32 v152, 16, v154
v_and_b32 v153, 0xffff0000, v154
v_mul_f32 v150, 0x3fb8aa3b, v150
v_mul_f32 v151, 0x3fb8aa3b, v151
v_mul_f32 v152, 0x3fb8aa3b, v152
v_mul_f32 v153, 0x3fb8aa3b, v153
v_exp_f32 v150, v150
v_exp_f32 v151, v151
v_exp_f32 v152, v152
v_exp_f32 v153, v153
s_nop 0
v_cvt_pk_bf16_f32 v80, v150, v151
v_cvt_pk_bf16_f32 v81, v152, v153
v_lshlrev_b32 v82, 16, v82
v_sub_f32 v150, v82, v64
v_sub_f32 v151, v82, v65
v_sub_f32 v152, v82, v66
v_sub_f32 v153, v82, v67
v_cvt_pk_bf16_f32 v154, v150, v151
v_lshlrev_b32 v150, 16, v154
v_and_b32 v151, 0xffff0000, v154
v_cvt_pk_bf16_f32 v154, v152, v153
v_lshlrev_b32 v152, 16, v154
v_and_b32 v153, 0xffff0000, v154
v_mul_f32 v150, v150, v150
v_mul_f32 v151, v151, v151
v_mul_f32 v152, v152, v152
v_mul_f32 v153, v153, v153
v_cvt_pk_bf16_f32 v154, v150, v151
v_lshlrev_b32 v150, 16, v154
v_and_b32 v151, 0xffff0000, v154
v_cvt_pk_bf16_f32 v154, v152, v153
v_lshlrev_b32 v152, 16, v154
v_and_b32 v153, 0xffff0000, v154
v_mul_f32 v150, 0xc1200000, v150
v_mul_f32 v151, 0xc1200000, v151
v_mul_f32 v152, 0xc1200000, v152
v_mul_f32 v153, 0xc1200000, v153
v_cvt_pk_bf16_f32 v154, v150, v151
v_lshlrev_b32 v150, 16, v154
v_and_b32 v151, 0xffff0000, v154
v_cvt_pk_bf16_f32 v154, v152, v153
v_lshlrev_b32 v152, 16, v154
v_and_b32 v153, 0xffff0000, v154
v_mul_f32 v150, 0x3fb8aa3b, v150
v_mul_f32 v151, 0x3fb8aa3b, v151
v_mul_f32 v152, 0x3fb8aa3b, v152
v_mul_f32 v153, 0x3fb8aa3b, v153
v_exp_f32 v150, v150
v_exp_f32 v151, v151
v_exp_f32 v152, v152
v_exp_f32 v153, v153
s_nop 0
v_cvt_pk_bf16_f32 v82, v150, v151
v_cvt_pk_bf16_f32 v83, v152, v153
s_setpc_b64 s[76:77]
K2_FLUSH:
s_mul_i32 s33, s33, 43
s_bfe_u32 s36, s33, 0x20008
s_cmp_lg_u32 s36, 0
s_cbranch_scc1 K2_F1
v_add_f32 v16, v16, v134
v_add_f32 v17, v17, v135
v_add_f32 v18, v18, v136
v_add_f32 v19, v19, v137
v_add_f32 v20, v20, v138
v_add_f32 v21, v21, v139
v_add_f32 v22, v22, v140
v_add_f32 v23, v23, v141
s_cmp_lt_u32 s33, s101
s_cbranch_scc1 K2_FZ
K2_E0:
s_bitset1_b32 s87, 0
v_mfma_f32_16x16x16_bf16 v[120:123], v[58:59], v[76:77], 0
v_mfma_f32_16x16x16_bf16 v[124:127], v[60:61], v[76:77], 0
v_mfma_f32_16x16x16_bf16 v[128:131], v[62:63], v[76:77], 0
s_nop 7
v_mul_f32 v112, v16, v120
v_mul_f32 v113, v17, v121
v_mul_f32 v114, v18, v122
v_mul_f32 v115, v19, v123
v_fmac_f32 v112, v20, v124
v_fmac_f32 v113, v21, v125
v_fmac_f32 v114, v22, v126
v_fmac_f32 v115, v23, v127
v_cvt_pk_bf16_f32 v108, v112, v113
v_cvt_pk_bf16_f32 v109, v114, v115
s_nop 1
v_mfma_f32_16x16x16_bf16 v[116:119], v[56:57], v[108:109], 0
v_lshlrev_b32 v104, 16, v68
v_and_b32 v105, 0xffff0000, v68
v_lshlrev_b32 v106, 16, v69
v_and_b32 v107, 0xffff0000, v69
s_nop 4
v_fmac_f32 v104, v116, v128
v_fmac_f32 v105, v117, v129
v_fmac_f32 v106, v118, v130
v_fmac_f32 v107, v119, v131
v_cvt_pk_bf16_f32 v68, v104, v105
v_cvt_pk_bf16_f32 v69, v106, v107
buffer_store_dwordx2 v[68:69], v8, s[16:19], 0 offen offset:0
s_branch K2_FZ
K2_F1:
s_cmp_lg_u32 s36, 1
s_cbranch_scc1 K2_F2
v_add_f32 v24, v24, v134
v_add_f32 v25, v25, v135
v_add_f32 v26, v26, v136
v_add_f32 v27, v27, v137
v_add_f32 v28, v28, v138
v_add_f32 v29, v29, v139
v_add_f32 v30, v30, v140
v_add_f32 v31, v31, v141
s_cmp_lt_u32 s33, s101
s_cbranch_scc1 K2_FZ
K2_E1:
s_bitset1_b32 s87, 1
v_mfma_f32_16x16x16_bf16 v[120:123], v[58:59], v[78:79], 0
v_mfma_f32_16x16x16_bf16 v[124:127], v[60:61], v[78:79], 0
v_mfma_f32_16x16x16_bf16 v[128:131], v[62:63], v[78:79], 0
s_nop 7
v_mul_f32 v112, v24, v120
v_mul_f32 v113, v25, v121
v_mul_f32 v114, v26, v122
v_mul_f32 v115, v27, v123
v_fmac_f32 v112, v28, v124
v_fmac_f32 v113, v29, v125
v_fmac_f32 v114, v30, v126
v_fmac_f32 v115, v31, v127
v_cvt_pk_bf16_f32 v108, v112, v113
v_cvt_pk_bf16_f32 v109, v114, v115
s_nop 1
v_mfma_f32_16x16x16_bf16 v[116:119], v[56:57], v[108:109], 0
v_lshlrev_b32 v104, 16, v70
v_and_b32 v105, 0xffff0000, v70
v_lshlrev_b32 v106, 16, v71
v_and_b32 v107, 0xffff0000, v71
s_nop 4
v_fmac_f32 v104, v116, v128
v_fmac_f32 v105, v117, v129
v_fmac_f32 v106, v118, v130
v_fmac_f32 v107, v119, v131
v_cvt_pk_bf16_f32 v70, v104, v105
v_cvt_pk_bf16_f32 v71, v106, v107
buffer_store_dwordx2 v[70:71], v8, s[16:19], 0 offen offset:512
s_branch K2_FZ
K2_F2:
s_cmp_lg_u32 s36, 2
s_cbranch_scc1 K2_F3
v_add_f32 v32, v32, v134
v_add_f32 v33, v33, v135
v_add_f32 v34, v34, v136
v_add_f32 v35, v35, v137
v_add_f32 v36, v36, v138
v_add_f32 v37, v37, v139
v_add_f32 v38, v38, v140
v_add_f32 v39, v39, v141
s_cmp_lt_u32 s33, s101
s_cbranch_scc1 K2_FZ
K2_E2:
s_bitset1_b32 s87, 2
v_mfma_f32_16x16x16_bf16 v[120:123], v[58:59], v[80:81], 0
v_mfma_f32_16x16x16_bf16 v[124:127], v[60:61], v[80:81], 0
v_mfma_f32_16x16x16_bf16 v[128:131], v[62:63], v[80:81], 0
s_nop 7
v_mul_f32 v112, v32, v120
v_mul_f32 v113, v33, v121
v_mul_f32 v114, v34, v122
v_mul_f32 v115, v35, v123
v_fmac_f32 v112, v36, v124
v_fmac_f32 v113, v37, v125
v_fmac_f32 v114, v38, v126
v_fmac_f32 v115, v39, v127
v_cvt_pk_bf16_f32 v108, v112, v113
v_cvt_pk_bf16_f32 v109, v114, v115
s_nop 1
v_mfma_f32_16x16x16_bf16 v[116:119], v[56:57], v[108:109], 0
v_lshlrev_b32 v104, 16, v72
v_and_b32 v105, 0xffff0000, v72
v_lshlrev_b32 v106, 16, v73
v_and_b32 v107, 0xffff0000, v73
s_nop 4
v_fmac_f32 v104, v116, v128
v_fmac_f32 v105, v117, v129
v_fmac_f32 v106, v118, v130
v_fmac_f32 v107, v119, v131
v_cvt_pk_bf16_f32 v72, v104, v105
v_cvt_pk_bf16_f32 v73, v106, v107
buffer_store_dwordx2 v[72:73], v8, s[16:19], 0 offen offset:1024
s_branch K2_FZ
K2_F3:
v_add_f32 v40, v40, v134
v_add_f32 v41, v41, v135
v_add_f32 v42, v42, v136
v_add_f32 v43, v43, v137
v_add_f32 v44, v44, v138
v_add_f32 v45, v45, v139
v_add_f32 v46, v46, v140
v_add_f32 v47, v47, v141
s_cmp_lt_u32 s33, s101
s_cbranch_scc1 K2_FZ
K2_E3:
s_bitset1_b32 s87, 3
v_mfma_f32_16x16x16_bf16 v[120:123], v[58:59], v[82:83], 0
v_mfma_f32_16x16x16_bf16 v[124:127], v[60:61], v[82:83], 0
v_mfma_f32_16x16x16_bf16 v[128:131], v[62:63], v[82:83], 0
s_nop 7
v_mul_f32 v112, v40, v120
v_mul_f32 v113, v41, v121
v_mul_f32 v114, v42, v122
v_mul_f32 v115, v43, v123
v_fmac_f32 v112, v44, v124
v_fmac_f32 v113, v45, v125
v_fmac_f32 v114, v46, v126
v_fmac_f32 v115, v47, v127
v_cvt_pk_bf16_f32 v108, v112, v113
v_cvt_pk_bf16_f32 v109, v114, v115
s_nop 1
v_mfma_f32_16x16x16_bf16 v[116:119], v[56:57], v[108:109], 0
v_lshlrev_b32 v104, 16, v74
v_and_b32 v105, 0xffff0000, v74
v_lshlrev_b32 v106, 16, v75
v_and_b32 v107, 0xffff0000, v75
s_nop 4
v_fmac_f32 v104, v116, v128
v_fmac_f32 v105, v117, v129
v_fmac_f32 v106, v118, v130
v_fmac_f32 v107, v119, v131
v_cvt_pk_bf16_f32 v74, v104, v105
v_cvt_pk_bf16_f32 v75, v106, v107
buffer_store_dwordx2 v[74:75], v8, s[16:19], 0 offen offset:1536
K2_FZ:
v_mov_b32 v134, 0
v_mov_b32 v135, 0
v_mov_b32 v136, 0
v_mov_b32 v137, 0
v_mov_b32 v138, 0
v_mov_b32 v139, 0
v_mov_b32 v140, 0
v_mov_b32 v141, 0
s_cmp_eq_u64 s[26:27], 0
s_setpc_b64 s[34:35]
K2_MDONE:
s_cmp_lg_u32 s101, 1024
s_cbranch_scc1 K2_SLOWNEXT
s_cmp_eq_u32 s87, 15
s_cbranch_scc1 K2_D3
K2_EPI:
s_waitcnt vmcnt(0)
s_bitcmp1_b32 s87, 0
s_cbranch_scc1 K2_D0
s_call_b64 s[34:35], K2_E0
K2_D0:
s_bitcmp1_b32 s87, 1
s_cbranch_scc1 K2_D1
s_call_b64 s[34:35], K2_E1
K2_D1:
s_bitcmp1_b32 s87, 2
s_cbranch_scc1 K2_D2
s_call_b64 s[34:35], K2_E2
K2_D2:
s_bitcmp1_b32 s87, 3
s_cbranch_scc1 K2_D3
s_call_b64 s[34:35], K2_E3
K2_D3:
K2_END:
s_endpgm
K2_SLOWINIT:
s_mov_b32 s101, -1
s_mov_b32 s96, -1
s_mov_b32 s98, 0
s_mov_b32 s99, 0
K2_SLOWNEXT:
s_add_u32 s98, s98, 768
s_mov_b32 s74, 0
K2_SLOWADV:
s_cmp_lt_u32 s98, s99
s_cbranch_scc1 K2_SLOWGO
s_add_u32 s96, s96, 1
s_cmp_ge_u32 s96, 250
s_cbranch_scc1 K2_SLOWEND
s_mul_i32 s20, s96, 2622
s_lshr_b32 s20, s20, 16
s_mul_i32 s20, s20, 56
s_lshl_b32 s21, s96, 3
s_add_u32 s20, s20, s21
s_mul_i32 s21, s2, 2560
s_add_u32 s20, s20, s21
s_add_u32 s20, s20, 20480000
s_load_dwordx2 s[98:99], s[4:5], s20
s_waitcnt lgkmcnt(0)
s_min_u32 s99, s99, 10240000
s_branch K2_SLOWADV
K2_SLOWEND:
s_branch K2_EPI
K2_SLOWGO:
s_waitcnt vmcnt(0) lgkmcnt(0)
s_barrier
v_and_b32 v12, 0x78, v0
v_bfe_u32 v13, v0, 1, 2
v_and_b32 v11, 1, v0
v_lshl_or_b32 v12, v11, 2, v12
v_or_b32 v12, v12, v13
v_mul_u32_u24 v12, 1536, v12
v_add_u32 v11, 22272, v12
v_and_b32 v13, 127, v0
v_lshlrev_b32 v13, 2, v13
ds_write_b32 v13, v11 offset:0
s_mul_i32 s20, s3, 12288
s_add_u32 s20, s20, 22272
v_lshl_add_u32 v11, v10, 4, s20
v_mov_b32 v12, -1
v_mov_b32 v13, 0
v_mov_b32 v14, -1
v_mov_b32 v15, 0
ds_write_b128 v11, v[12:15]
s_waitcnt lgkmcnt(0)
s_barrier
s_cmp_ge_u32 s3, 3
s_cbranch_scc1 K2_COMMON
s_lshl_b32 s20, s3, 8
s_add_u32 s20, s20, s98
s_mov_b32 s6, s99
buffer_load_dword v134, v164, s[4:7], s20 offen
s_lshr_b32 s21, s20, 1
buffer_load_ushort v135, v165, s[92:95], s21 offen
s_waitcnt vmcnt(0)
v_cmpx_ne_u32 vcc, 0, v134
v_lshrrev_b32 v146, 23, v134
ds_add_rtn_u32 v146, v146, v9 offset:0
s_waitcnt lgkmcnt(0)
v_min_u32 v146, 145144, v146
ds_write_b64 v146, v[134:135]
s_mov_b64 exec, -1
s_branch K2_COMMON
.section .rodata,"a"
.p2align 6
.amdhsa_kernel acc_kernel
  .amdhsa_next_free_vgpr 168
  .amdhsa_next_free_sgpr 102
  .amdhsa_accum_offset 168
  .amdhsa_group_segment_fixed_size 0
  .amdhsa_kernarg_size 112
  .amdhsa_user_sgpr_count 2
  .amdhsa_user_sgpr_kernarg_segment_ptr 1
  .amdhsa_system_sgpr_workgroup_id_x 1
.end_amdhsa_kernel
```
